```python
import torch

def _softmax(x, axis=-1):
    return torch.softmax(x, dim=axis)
def _gelu(x):
    return torch.nn.functional.gelu(x, approximate="tanh")
def _silu(x):
    return torch.nn.functional.silu(x)
def _sigmoid(x):
    return torch.sigmoid(x)
def _layernorm(x, axis=-1, eps=1e-5):
    m = x.mean(dim=axis, keepdim=True)
    v = x.var(dim=axis, keepdim=True, unbiased=False)
    return (x - m) / torch.sqrt(v + eps)
def _scatter_add(tgt, idx, src, axis=0):
    return tgt.clone().index_add_(axis, idx, src)
def _segment_sum(src, seg, n):
    out = torch.zeros((n,) + src.shape[1:], dtype=src.dtype)
    return out.index_add_(0, seg, src)
def _pad(x, pw):
    flat = tuple(v for pair in reversed(pw) for v in pair)
    return torch.nn.functional.pad(x, flat)

kernel_name = 'standalone__low_rank_proj_linformer__prompt'

def setup_inputs():

    _w = (lambda a: (lambda t: t.to(torch.bfloat16) if t.is_floating_point() else t)(torch.as_tensor(a)))
    B, H, Sq, Skv, Dh, R = 1, 32, 2048, 2048, 128, 8
    return {
        "q": _w((lambda *s: torch.randn(*s, dtype=torch.bfloat16) * 0.8)(B, H, Sq, Dh)),
        "k": _w((lambda *s: torch.randn(*s, dtype=torch.bfloat16) * 0.8)(B, H, Skv, Dh)),
        "v": _w((lambda *s: torch.randn(*s, dtype=torch.bfloat16) * 0.05)(B, H, Skv, Dh)),
        "e_proj": _w((lambda *s: torch.randn(*s, dtype=torch.bfloat16) * 0.8)(R, Skv) * (Skv ** -0.5)),
        "f_proj": _w((lambda *s: torch.randn(*s, dtype=torch.bfloat16) * 0.05)(R, Skv) * (Skv ** -0.5)),
    }

def reference(q, k, v, e_proj, f_proj):
    B, H, Sq, Dh = q.shape
    kp = torch.einsum("rn,bhnd->bhrd", e_proj, k)
    vp = torch.einsum("rn,bhnd->bhrd", f_proj, v)
    scores = torch.einsum("bhqd,bhrd->bhqr", q, kp) * (Dh ** -0.5)
    p = _softmax(scores, axis=-1)
    o = torch.einsum("bhqr,bhrd->bhqd", p, vp)
    return o
```

```asm
; @launch kernel=proj_kernel grid=(256,1,1) block=(512,1,1) lds=131072
; @launch kernel=attn_kernel grid=(256,1,1) block=(512,1,1) lds=4096
.amdgcn_target "amdgcn-amd-amdhsa--gfx950"
.text
.globl proj_kernel
.p2align 8
.type proj_kernel,@function
proj_kernel:
    s_cmp_ge_u32 s2, 256
    s_cbranch_scc1 L_end1
    s_load_dwordx4 s[4:7], s[0:1], 8
    s_load_dwordx4 s[8:11], s[0:1], 24
    s_load_dwordx2 s[12:13], s[0:1], 56
    s_lshr_b32 s14, s2, 3
    s_lshr_b32 s15, s2, 2
    s_and_b32 s15, s15, 1
    s_and_b32 s16, s2, 3
    v_and_b32 v1, 63, v0
    v_lshrrev_b32 v2, 6, v0
    v_and_b32 v3, 15, v0
    v_readfirstlane_b32 s17, v2
    v_lshrrev_b32 v2, 4, v1
    s_lshl_b32 s18, s17, 14
    v_lshlrev_b32 v5, 1, v2
    v_xor_b32 v5, v5, v3
    v_lshlrev_b32 v5, 4, v5
    v_lshl_add_u32 v4, v2, 8, v5
    v_xor_b32 v5, 128, v4
    s_lshl_b32 s19, s16, 10
    s_lshl_b32 s20, s17, 7
    s_add_u32 s19, s19, s20
    v_lshlrev_b32 v6, 12, v3
    v_lshl_add_u32 v6, v2, 4, v6
    v_add_u32 v6, s19, v6
    v_lshrrev_b32 v7, 2, v3
    v_and_b32 v16, 1, v2
    v_lshl_or_b32 v16, v16, 2, v7
    v_lshl_add_u32 v17, v2, 3, v7
    v_lshlrev_b32 v17, 8, v17
    v_and_b32 v18, 3, v3
    v_lshl_add_u32 v17, v18, 3, v17
    v_add_u32 v17, s18, v17
    v_xor_b32 v18, 0, v16
    v_lshl_add_u32 v8, v18, 5, v17
    v_xor_b32 v18, 1, v16
    v_lshl_add_u32 v9, v18, 5, v17
    v_xor_b32 v18, 2, v16
    v_lshl_add_u32 v10, v18, 5, v17
    v_xor_b32 v18, 3, v16
    v_lshl_add_u32 v11, v18, 5, v17
    v_xor_b32 v18, 4, v16
    v_lshl_add_u32 v12, v18, 5, v17
    v_xor_b32 v18, 5, v16
    v_lshl_add_u32 v13, v18, 5, v17
    v_xor_b32 v18, 6, v16
    v_lshl_add_u32 v14, v18, 5, v17
    v_xor_b32 v18, 7, v16
    v_lshl_add_u32 v15, v18, 5, v17
    s_waitcnt lgkmcnt(0)
    s_cmp_eq_u32 s15, 0
    s_cselect_b64 s[20:21], s[4:5], s[6:7]
    s_cselect_b64 s[22:23], s[8:9], s[10:11]
    s_lshl_b32 s24, s14, 19
    s_lshl_b32 s25, s16, 17
    s_add_u32 s25, s24, s25
    s_add_u32 s24, s20, s25
    s_addc_u32 s25, s21, 0
    s_mov_b32 s26, 131072
    s_mov_b32 s27, 0x20000
    s_mov_b32 s28, s22
    s_mov_b32 s29, s23
    s_mov_b32 s30, 32768
    s_mov_b32 s31, 0x20000
    s_mov_b32 s32, s12
    s_mov_b32 s33, s13
    s_mov_b32 s34, 1048576
    s_mov_b32 s35, 0x20000
    buffer_load_dwordx4 v[20:23], v6, s[28:31], 0 offen
    buffer_load_dwordx4 v[24:27], v6, s[28:31], 0 offen offset:64
    s_add_u32 s36, s18, 0
    s_mov_b32 m0, s36
    s_nop 0
    buffer_load_dwordx4 v4, s[24:27], s36 offen nt lds
    buffer_load_dwordx4 v4, s[24:27], s36 offen offset:1024 nt lds
    buffer_load_dwordx4 v5, s[24:27], s36 offen offset:2048 nt lds
    buffer_load_dwordx4 v5, s[24:27], s36 offen offset:3072 nt lds
    s_add_u32 s36, s18, 4096
    s_mov_b32 m0, s36
    s_nop 0
    buffer_load_dwordx4 v4, s[24:27], s36 offen nt lds
    buffer_load_dwordx4 v4, s[24:27], s36 offen offset:1024 nt lds
    buffer_load_dwordx4 v5, s[24:27], s36 offen offset:2048 nt lds
    buffer_load_dwordx4 v5, s[24:27], s36 offen offset:3072 nt lds
    s_add_u32 s36, s18, 8192
    s_mov_b32 m0, s36
    s_nop 0
    buffer_load_dwordx4 v4, s[24:27], s36 offen nt lds
    buffer_load_dwordx4 v4, s[24:27], s36 offen offset:1024 nt lds
    buffer_load_dwordx4 v5, s[24:27], s36 offen offset:2048 nt lds
    buffer_load_dwordx4 v5, s[24:27], s36 offen offset:3072 nt lds
    s_add_u32 s36, s18, 12288
    s_mov_b32 m0, s36
    s_nop 0
    buffer_load_dwordx4 v4, s[24:27], s36 offen nt lds
    buffer_load_dwordx4 v4, s[24:27], s36 offen offset:1024 nt lds
    buffer_load_dwordx4 v5, s[24:27], s36 offen offset:2048 nt lds
    buffer_load_dwordx4 v5, s[24:27], s36 offen offset:3072 nt lds
    s_waitcnt vmcnt(8)
    ds_read_b64_tr_b16 v[28:29], v8 offset:0
    ds_read_b64_tr_b16 v[30:31], v8 offset:1024
    ds_read_b64_tr_b16 v[32:33], v9 offset:0
    ds_read_b64_tr_b16 v[34:35], v9 offset:1024
    ds_read_b64_tr_b16 v[36:37], v10 offset:0
    ds_read_b64_tr_b16 v[38:39], v10 offset:1024
    ds_read_b64_tr_b16 v[40:41], v11 offset:0
    ds_read_b64_tr_b16 v[42:43], v11 offset:1024
    ds_read_b64_tr_b16 v[44:45], v12 offset:0
    ds_read_b64_tr_b16 v[46:47], v12 offset:1024
    ds_read_b64_tr_b16 v[48:49], v13 offset:0
    ds_read_b64_tr_b16 v[50:51], v13 offset:1024
    ds_read_b64_tr_b16 v[52:53], v14 offset:0
    ds_read_b64_tr_b16 v[54:55], v14 offset:1024
    ds_read_b64_tr_b16 v[56:57], v15 offset:0
    ds_read_b64_tr_b16 v[58:59], v15 offset:1024
    s_waitcnt lgkmcnt(14)
    v_mfma_f32_16x16x32_bf16 v[92:95], v[20:23], v[28:31], 0
    s_waitcnt lgkmcnt(12)
    v_mfma_f32_16x16x32_bf16 v[96:99], v[20:23], v[32:35], 0
    s_waitcnt lgkmcnt(10)
    v_mfma_f32_16x16x32_bf16 v[100:103], v[20:23], v[36:39], 0
    s_waitcnt lgkmcnt(8)
    v_mfma_f32_16x16x32_bf16 v[104:107], v[20:23], v[40:43], 0
    s_waitcnt lgkmcnt(6)
    v_mfma_f32_16x16x32_bf16 v[108:111], v[20:23], v[44:47], 0
    s_waitcnt lgkmcnt(4)
    v_mfma_f32_16x16x32_bf16 v[112:115], v[20:23], v[48:51], 0
    s_waitcnt lgkmcnt(2)
    v_mfma_f32_16x16x32_bf16 v[116:119], v[20:23], v[52:55], 0
    s_waitcnt lgkmcnt(0)
    v_mfma_f32_16x16x32_bf16 v[120:123], v[20:23], v[56:59], 0
    s_waitcnt vmcnt(0)
    ds_read_b64_tr_b16 v[60:61], v8 offset:8192
    ds_read_b64_tr_b16 v[62:63], v8 offset:9216
    ds_read_b64_tr_b16 v[64:65], v9 offset:8192
    ds_read_b64_tr_b16 v[66:67], v9 offset:9216
    ds_read_b64_tr_b16 v[68:69], v10 offset:8192
    ds_read_b64_tr_b16 v[70:71], v10 offset:9216
    ds_read_b64_tr_b16 v[72:73], v11 offset:8192
    ds_read_b64_tr_b16 v[74:75], v11 offset:9216
    ds_read_b64_tr_b16 v[76:77], v12 offset:8192
    ds_read_b64_tr_b16 v[78:79], v12 offset:9216
    ds_read_b64_tr_b16 v[80:81], v13 offset:8192
    ds_read_b64_tr_b16 v[82:83], v13 offset:9216
    ds_read_b64_tr_b16 v[84:85], v14 offset:8192
    ds_read_b64_tr_b16 v[86:87], v14 offset:9216
    ds_read_b64_tr_b16 v[88:89], v15 offset:8192
    ds_read_b64_tr_b16 v[90:91], v15 offset:9216
    s_waitcnt lgkmcnt(14)
    v_mfma_f32_16x16x32_bf16 v[92:95], v[24:27], v[60:63], v[92:95]
    s_waitcnt lgkmcnt(12)
    v_mfma_f32_16x16x32_bf16 v[96:99], v[24:27], v[64:67], v[96:99]
    s_waitcnt lgkmcnt(10)
    v_mfma_f32_16x16x32_bf16 v[100:103], v[24:27], v[68:71], v[100:103]
    s_waitcnt lgkmcnt(8)
    v_mfma_f32_16x16x32_bf16 v[104:107], v[24:27], v[72:75], v[104:107]
    s_waitcnt lgkmcnt(6)
    v_mfma_f32_16x16x32_bf16 v[108:111], v[24:27], v[76:79], v[108:111]
    s_waitcnt lgkmcnt(4)
    v_mfma_f32_16x16x32_bf16 v[112:115], v[24:27], v[80:83], v[112:115]
    s_waitcnt lgkmcnt(2)
    v_mfma_f32_16x16x32_bf16 v[116:119], v[24:27], v[84:87], v[116:119]
    s_waitcnt lgkmcnt(0)
    v_mfma_f32_16x16x32_bf16 v[120:123], v[24:27], v[88:91], v[120:123]
    v_lshlrev_b32 v16, 11, v2
    v_lshl_add_u32 v16, v3, 2, v16
    v_add_u32 v16, s18, v16
    s_nop 7
    ds_write_b32 v16, v92 offset:0
    ds_write_b32 v16, v93 offset:512
    ds_write_b32 v16, v94 offset:1024
    ds_write_b32 v16, v95 offset:1536
    ds_write_b32 v16, v96 offset:64
    ds_write_b32 v16, v97 offset:576
    ds_write_b32 v16, v98 offset:1088
    ds_write_b32 v16, v99 offset:1600
    ds_write_b32 v16, v100 offset:128
    ds_write_b32 v16, v101 offset:640
    ds_write_b32 v16, v102 offset:1152
    ds_write_b32 v16, v103 offset:1664
    ds_write_b32 v16, v104 offset:192
    ds_write_b32 v16, v105 offset:704
    ds_write_b32 v16, v106 offset:1216
    ds_write_b32 v16, v107 offset:1728
    ds_write_b32 v16, v108 offset:256
    ds_write_b32 v16, v109 offset:768
    ds_write_b32 v16, v110 offset:1280
    ds_write_b32 v16, v111 offset:1792
    ds_write_b32 v16, v112 offset:320
    ds_write_b32 v16, v113 offset:832
    ds_write_b32 v16, v114 offset:1344
    ds_write_b32 v16, v115 offset:1856
    ds_write_b32 v16, v116 offset:384
    ds_write_b32 v16, v117 offset:896
    ds_write_b32 v16, v118 offset:1408
    ds_write_b32 v16, v119 offset:1920
    ds_write_b32 v16, v120 offset:448
    ds_write_b32 v16, v121 offset:960
    ds_write_b32 v16, v122 offset:1472
    ds_write_b32 v16, v123 offset:1984
    v_lshlrev_b32 v17, 3, v0
    v_add_u32 v18, 0x10000, v17
    s_waitcnt lgkmcnt(0)
    s_barrier
    ds_read_b64 v[28:29], v17 offset:0
    ds_read_b64 v[30:31], v17 offset:16384
    ds_read_b64 v[32:33], v17 offset:32768
    ds_read_b64 v[34:35], v17 offset:49152
    ds_read_b64 v[36:37], v18 offset:0
    ds_read_b64 v[38:39], v18 offset:16384
    ds_read_b64 v[40:41], v18 offset:32768
    ds_read_b64 v[42:43], v18 offset:49152
    s_lshl_b32 s36, s2, 12
    s_waitcnt lgkmcnt(6)
    v_add_f32 v28, v28, v30
    v_add_f32 v29, v29, v31
    s_waitcnt lgkmcnt(5)
    v_add_f32 v28, v28, v32
    v_add_f32 v29, v29, v33
    s_waitcnt lgkmcnt(4)
    v_add_f32 v28, v28, v34
    v_add_f32 v29, v29, v35
    s_waitcnt lgkmcnt(3)
    v_add_f32 v28, v28, v36
    v_add_f32 v29, v29, v37
    s_waitcnt lgkmcnt(2)
    v_add_f32 v28, v28, v38
    v_add_f32 v29, v29, v39
    s_waitcnt lgkmcnt(1)
    v_add_f32 v28, v28, v40
    v_add_f32 v29, v29, v41
    s_waitcnt lgkmcnt(0)
    v_add_f32 v28, v28, v42
    v_add_f32 v29, v29, v43
    buffer_store_dwordx2 v[28:29], v17, s[32:35], s36 offen
L_end1:
    s_endpgm
.globl attn_kernel
.p2align 8
.type attn_kernel,@function
attn_kernel:
    s_cmp_ge_u32 s2, 256
    s_cbranch_scc1 L_end2
    s_load_dwordx2 s[4:5], s[0:1], 0
    s_load_dwordx2 s[6:7], s[0:1], 40
    s_load_dwordx2 s[8:9], s[0:1], 56
    s_lshl_b32 s10, s2, 16
    s_lshr_b32 s11, s2, 3
    s_lshl_b32 s11, s11, 15
    v_and_b32 v1, 63, v0
    v_and_b32 v3, 15, v0
    v_lshrrev_b32 v2, 4, v1
    v_lshrrev_b32 v7, 6, v0
    v_lshl_add_u32 v4, v7, 5, v3
    v_lshlrev_b32 v4, 8, v4
    v_lshl_add_u32 v4, v2, 4, v4
    v_add_u32 v5, 4096, v4
    v_and_b32 v6, 511, v0
    v_and_b32 v7, 7, v7
    v_lshlrev_b32 v6, 3, v6
    s_mov_b32 s40, 0
    s_mov_b32 s41, 4096
    s_mov_b32 s42, 8192
    s_mov_b32 s43, 12288
    s_mov_b32 s44, 16384
    s_mov_b32 s45, 20480
    s_mov_b32 s46, 24576
    s_mov_b32 s47, 28672
    s_waitcnt lgkmcnt(0)
    s_add_u32 s12, s4, s10
    s_addc_u32 s13, s5, 0
    s_mov_b32 s14, 65536
    s_mov_b32 s15, 0x20000
    s_add_u32 s16, s6, s10
    s_addc_u32 s17, s7, 0
    s_mov_b32 s18, 65536
    s_mov_b32 s19, 0x20000
    s_add_u32 s20, s8, s11
    s_addc_u32 s21, s9, 0
    s_mov_b32 s22, 32768
    s_mov_b32 s23, 0x20000
    buffer_load_dwordx2 v[48:49], v6, s[20:23], s40 offen
    buffer_load_dwordx2 v[50:51], v6, s[20:23], s41 offen
    buffer_load_dwordx2 v[52:53], v6, s[20:23], s42 offen
    buffer_load_dwordx2 v[54:55], v6, s[20:23], s43 offen
    buffer_load_dwordx2 v[56:57], v6, s[20:23], s44 offen
    buffer_load_dwordx2 v[58:59], v6, s[20:23], s45 offen
    buffer_load_dwordx2 v[60:61], v6, s[20:23], s46 offen
    buffer_load_dwordx2 v[62:63], v6, s[20:23], s47 offen
    buffer_load_dwordx4 v[16:19], v4, s[12:15], 0 offen nt
    buffer_load_dwordx4 v[20:23], v4, s[12:15], 0 offen offset:64 nt
    buffer_load_dwordx4 v[24:27], v4, s[12:15], 0 offen offset:128 nt
    buffer_load_dwordx4 v[28:31], v4, s[12:15], 0 offen offset:192 nt
    buffer_load_dwordx4 v[32:35], v5, s[12:15], 0 offen nt
    buffer_load_dwordx4 v[36:39], v5, s[12:15], 0 offen offset:64 nt
    buffer_load_dwordx4 v[40:43], v5, s[12:15], 0 offen offset:128 nt
    buffer_load_dwordx4 v[44:47], v5, s[12:15], 0 offen offset:192 nt
    v_mov_b32 v80, 0
    v_mov_b32 v81, 0
    v_mov_b32 v82, 0
    v_mov_b32 v83, 0
    v_mov_b32 v84, 0
    v_mov_b32 v85, 0
    v_mov_b32 v86, 0
    v_mov_b32 v87, 0
    v_mov_b32 v88, 0
    v_mov_b32 v89, 0
    v_mov_b32 v90, 0
    v_mov_b32 v91, 0
    v_mov_b32 v92, 0
    v_mov_b32 v93, 0
    v_mov_b32 v94, 0
    v_mov_b32 v95, 0
    v_and_b32 v8, 511, v0
    v_lshlrev_b32 v8, 2, v8
    v_and_b32 v9, 63, v0
    v_lshlrev_b32 v9, 5, v9
    v_lshl_add_u32 v9, v7, 1, v9
    s_waitcnt vmcnt(8)
    v_add_f32 v48, v48, v50
    v_add_f32 v49, v49, v51
    v_add_f32 v48, v48, v52
    v_add_f32 v49, v49, v53
    v_add_f32 v48, v48, v54
    v_add_f32 v49, v49, v55
    v_add_f32 v56, v56, v58
    v_add_f32 v57, v57, v59
    v_add_f32 v56, v56, v60
    v_add_f32 v57, v57, v61
    v_add_f32 v56, v56, v62
    v_add_f32 v57, v57, v63
    v_cvt_pk_bf16_f32 v10, v48, v49
    v_cvt_pk_bf16_f32 v11, v56, v57
    ds_write_b32 v8, v10
    ds_write_b16 v9, v11 offset:2048
    ds_write_b16_d16_hi v9, v11 offset:2064
    v_and_b32 v10, 7, v3
    v_lshlrev_b32 v10, 8, v10
    v_lshl_add_u32 v10, v2, 4, v10
    v_lshrrev_b32 v11, 2, v3
    v_lshlrev_b32 v11, 3, v11
    v_and_b32 v12, 3, v3
    v_add_u32 v11, v11, v12
    v_lshlrev_b32 v11, 4, v11
    v_and_b32 v12, 1, v2
    v_lshl_add_u32 v11, v12, 3, v11
    s_waitcnt lgkmcnt(0)
    s_barrier
    ds_read_b128 v[64:67], v10 offset:0
    ds_read_b128 v[68:71], v10 offset:64
    ds_read_b128 v[72:75], v10 offset:128
    ds_read_b128 v[76:79], v10 offset:192
    s_mov_b32 exec_hi, 0
    ds_read_b64 v[80:81], v11 offset:2048
    ds_read_b64 v[82:83], v11 offset:2112
    ds_read_b64 v[84:85], v11 offset:2560
    ds_read_b64 v[86:87], v11 offset:2624
    ds_read_b64 v[88:89], v11 offset:3072
    ds_read_b64 v[90:91], v11 offset:3136
    ds_read_b64 v[92:93], v11 offset:3584
    ds_read_b64 v[94:95], v11 offset:3648
    s_mov_b32 exec_hi, -1
    s_mov_b32 s24, 0x3db504f3
    s_mov_b32 s25, 0x3fb8aa3b
    s_mov_b32 s26, 0xffff0000
    s_waitcnt lgkmcnt(0)
    s_waitcnt vmcnt(4)
    v_mfma_f32_16x16x32_bf16 v[96:99], v[64:67], v[16:19], 0
    v_mfma_f32_16x16x32_bf16 v[96:99], v[68:71], v[20:23], v[96:99]
    v_mfma_f32_16x16x32_bf16 v[96:99], v[72:75], v[24:27], v[96:99]
    v_mfma_f32_16x16x32_bf16 v[96:99], v[76:79], v[28:31], v[96:99]
    s_nop 7
    v_cvt_pk_bf16_f32 v12, v96, v97
    v_cvt_pk_bf16_f32 v13, v98, v99
    v_lshlrev_b32 v96, 16, v12
    v_and_b32 v97, s26, v12
    v_lshlrev_b32 v98, 16, v13
    v_and_b32 v99, s26, v13
    v_mul_f32 v96, s24, v96
    v_mul_f32 v97, s24, v97
    v_mul_f32 v98, s24, v98
    v_mul_f32 v99, s24, v99
    v_cvt_pk_bf16_f32 v12, v96, v97
    v_cvt_pk_bf16_f32 v13, v98, v99
    v_lshlrev_b32 v96, 16, v12
    v_and_b32 v97, s26, v12
    v_lshlrev_b32 v98, 16, v13
    v_and_b32 v99, s26, v13
    v_max_f32 v12, v96, v97
    v_max3_f32 v12, v12, v98, v99
    ds_swizzle_b32 v13, v12 offset:0x401F
    s_waitcnt lgkmcnt(0)
    v_max_f32 v12, v12, v13
    v_sub_f32 v96, v96, v12
    v_sub_f32 v97, v97, v12
    v_sub_f32 v98, v98, v12
    v_sub_f32 v99, v99, v12
    v_mul_f32 v96, s25, v96
    v_mul_f32 v97, s25, v97
    v_mul_f32 v98, s25, v98
    v_mul_f32 v99, s25, v99
    v_exp_f32 v96, v96
    v_exp_f32 v97, v97
    v_exp_f32 v98, v98
    v_exp_f32 v99, v99
    s_nop 0
    v_add_f32 v12, v96, v97
    v_add_f32 v13, v98, v99
    v_add_f32 v12, v12, v13
    ds_swizzle_b32 v13, v12 offset:0x401F
    s_waitcnt lgkmcnt(0)
    v_add_f32 v12, v12, v13
    v_rcp_f32 v12, v12
    s_nop 0
    v_mul_f32 v96, v96, v12
    v_mul_f32 v97, v97, v12
    v_mul_f32 v98, v98, v12
    v_mul_f32 v99, v99, v12
    v_cvt_pk_bf16_f32 v14, v96, v97
    v_cvt_pk_bf16_f32 v15, v98, v99
    s_nop 1
    v_mfma_f32_16x16x16_bf16 v[100:103], v[80:81], v[14:15], 0
    v_mfma_f32_16x16x16_bf16 v[104:107], v[82:83], v[14:15], 0
    v_mfma_f32_16x16x16_bf16 v[108:111], v[84:85], v[14:15], 0
    v_mfma_f32_16x16x16_bf16 v[112:115], v[86:87], v[14:15], 0
    v_mfma_f32_16x16x16_bf16 v[116:119], v[88:89], v[14:15], 0
    v_mfma_f32_16x16x16_bf16 v[120:123], v[90:91], v[14:15], 0
    v_mfma_f32_16x16x16_bf16 v[124:127], v[92:93], v[14:15], 0
    v_mfma_f32_16x16x16_bf16 v[128:131], v[94:95], v[14:15], 0
    s_nop 7
    v_cvt_pk_bf16_f32 v100, v100, v101
    v_cvt_pk_bf16_f32 v101, v102, v103
    v_cvt_pk_bf16_f32 v102, v104, v105
    v_cvt_pk_bf16_f32 v103, v106, v107
    buffer_store_dwordx4 v[100:103], v4, s[16:19], 0 offen
    v_cvt_pk_bf16_f32 v108, v108, v109
    v_cvt_pk_bf16_f32 v109, v110, v111
    v_cvt_pk_bf16_f32 v110, v112, v113
    v_cvt_pk_bf16_f32 v111, v114, v115
    buffer_store_dwordx4 v[108:111], v4, s[16:19], 0 offen offset:64
    v_cvt_pk_bf16_f32 v116, v116, v117
    v_cvt_pk_bf16_f32 v117, v118, v119
    v_cvt_pk_bf16_f32 v118, v120, v121
    v_cvt_pk_bf16_f32 v119, v122, v123
    buffer_store_dwordx4 v[116:119], v4, s[16:19], 0 offen offset:128
    v_cvt_pk_bf16_f32 v124, v124, v125
    v_cvt_pk_bf16_f32 v125, v126, v127
    v_cvt_pk_bf16_f32 v126, v128, v129
    v_cvt_pk_bf16_f32 v127, v130, v131
    buffer_store_dwordx4 v[124:127], v4, s[16:19], 0 offen offset:192
    s_waitcnt vmcnt(4)
    v_mfma_f32_16x16x32_bf16 v[96:99], v[64:67], v[32:35], 0
    v_mfma_f32_16x16x32_bf16 v[96:99], v[68:71], v[36:39], v[96:99]
    v_mfma_f32_16x16x32_bf16 v[96:99], v[72:75], v[40:43], v[96:99]
    v_mfma_f32_16x16x32_bf16 v[96:99], v[76:79], v[44:47], v[96:99]
    s_nop 7
    v_cvt_pk_bf16_f32 v12, v96, v97
    v_cvt_pk_bf16_f32 v13, v98, v99
    v_lshlrev_b32 v96, 16, v12
    v_and_b32 v97, s26, v12
    v_lshlrev_b32 v98, 16, v13
    v_and_b32 v99, s26, v13
    v_mul_f32 v96, s24, v96
    v_mul_f32 v97, s24, v97
    v_mul_f32 v98, s24, v98
    v_mul_f32 v99, s24, v99
    v_cvt_pk_bf16_f32 v12, v96, v97
    v_cvt_pk_bf16_f32 v13, v98, v99
    v_lshlrev_b32 v96, 16, v12
    v_and_b32 v97, s26, v12
    v_lshlrev_b32 v98, 16, v13
    v_and_b32 v99, s26, v13
    v_max_f32 v12, v96, v97
    v_max3_f32 v12, v12, v98, v99
    ds_swizzle_b32 v13, v12 offset:0x401F
    s_waitcnt lgkmcnt(0)
    v_max_f32 v12, v12, v13
    v_sub_f32 v96, v96, v12
    v_sub_f32 v97, v97, v12
    v_sub_f32 v98, v98, v12
    v_sub_f32 v99, v99, v12
    v_mul_f32 v96, s25, v96
    v_mul_f32 v97, s25, v97
    v_mul_f32 v98, s25, v98
    v_mul_f32 v99, s25, v99
    v_exp_f32 v96, v96
    v_exp_f32 v97, v97
    v_exp_f32 v98, v98
    v_exp_f32 v99, v99
    s_nop 0
    v_add_f32 v12, v96, v97
    v_add_f32 v13, v98, v99
    v_add_f32 v12, v12, v13
    ds_swizzle_b32 v13, v12 offset:0x401F
    s_waitcnt lgkmcnt(0)
    v_add_f32 v12, v12, v13
    v_rcp_f32 v12, v12
    s_nop 0
    v_mul_f32 v96, v96, v12
    v_mul_f32 v97, v97, v12
    v_mul_f32 v98, v98, v12
    v_mul_f32 v99, v99, v12
    v_cvt_pk_bf16_f32 v14, v96, v97
    v_cvt_pk_bf16_f32 v15, v98, v99
    s_nop 1
    v_mfma_f32_16x16x16_bf16 v[100:103], v[80:81], v[14:15], 0
    v_mfma_f32_16x16x16_bf16 v[104:107], v[82:83], v[14:15], 0
    v_mfma_f32_16x16x16_bf16 v[108:111], v[84:85], v[14:15], 0
    v_mfma_f32_16x16x16_bf16 v[112:115], v[86:87], v[14:15], 0
    v_mfma_f32_16x16x16_bf16 v[116:119], v[88:89], v[14:15], 0
    v_mfma_f32_16x16x16_bf16 v[120:123], v[90:91], v[14:15], 0
    v_mfma_f32_16x16x16_bf16 v[124:127], v[92:93], v[14:15], 0
    v_mfma_f32_16x16x16_bf16 v[128:131], v[94:95], v[14:15], 0
    s_nop 7
    v_cvt_pk_bf16_f32 v100, v100, v101
    v_cvt_pk_bf16_f32 v101, v102, v103
    v_cvt_pk_bf16_f32 v102, v104, v105
    v_cvt_pk_bf16_f32 v103, v106, v107
    buffer_store_dwordx4 v[100:103], v5, s[16:19], 0 offen
    v_cvt_pk_bf16_f32 v108, v108, v109
    v_cvt_pk_bf16_f32 v109, v110, v111
    v_cvt_pk_bf16_f32 v110, v112, v113
    v_cvt_pk_bf16_f32 v111, v114, v115
    buffer_store_dwordx4 v[108:111], v5, s[16:19], 0 offen offset:64
    v_cvt_pk_bf16_f32 v116, v116, v117
    v_cvt_pk_bf16_f32 v117, v118, v119
    v_cvt_pk_bf16_f32 v118, v120, v121
    v_cvt_pk_bf16_f32 v119, v122, v123
    buffer_store_dwordx4 v[116:119], v5, s[16:19], 0 offen offset:128
    v_cvt_pk_bf16_f32 v124, v124, v125
    v_cvt_pk_bf16_f32 v125, v126, v127
    v_cvt_pk_bf16_f32 v126, v128, v129
    v_cvt_pk_bf16_f32 v127, v130, v131
    buffer_store_dwordx4 v[124:127], v5, s[16:19], 0 offen offset:192
L_end2:
    s_endpgm
.section .rodata,"a"
.p2align 6
.amdhsa_kernel proj_kernel
  .amdhsa_next_free_vgpr 128
  .amdhsa_next_free_sgpr 64
  .amdhsa_accum_offset 128
  .amdhsa_group_segment_fixed_size 0
  .amdhsa_kernarg_size 64
  .amdhsa_user_sgpr_count 2
  .amdhsa_user_sgpr_kernarg_segment_ptr 1
  .amdhsa_system_sgpr_workgroup_id_x 1
.end_amdhsa_kernel
.p2align 6
.amdhsa_kernel attn_kernel
  .amdhsa_next_free_vgpr 136
  .amdhsa_next_free_sgpr 64
  .amdhsa_accum_offset 136
  .amdhsa_group_segment_fixed_size 0
  .amdhsa_kernarg_size 64
  .amdhsa_user_sgpr_count 2
  .amdhsa_user_sgpr_kernarg_segment_ptr 1
  .amdhsa_system_sgpr_workgroup_id_x 1
.end_amdhsa_kernel
```
